```python
import torch

def _softmax(x, axis=-1):
    return torch.softmax(x, dim=axis)

def _gelu(x):
    return torch.nn.functional.gelu(x, approximate='tanh')

def _silu(x):
    return torch.nn.functional.silu(x)

def _sigmoid(x):
    return torch.sigmoid(x)

def _layernorm(x, axis=-1, eps=1e-05):
    m = x.mean(dim=axis, keepdim=True)
    v = x.var(dim=axis, keepdim=True, unbiased=False)
    return (x - m) / torch.sqrt(v + eps)

def _scatter_add(tgt, idx, src, axis=0):
    return tgt.clone().index_add_(axis, idx, src)

def _segment_sum(src, seg, n):
    out = torch.zeros((n,) + src.shape[1:], dtype=src.dtype)
    return out.index_add_(0, seg, src)

def _pad(x, pw):
    flat = tuple((v for pair in reversed(pw) for v in pair))
    return torch.nn.functional.pad(x, flat)
kernel_name = 'standalone__tree_speculative_verify_tree_attention_over_candidate_token_tree__decode'

def setup_inputs():

    _w = lambda a: (lambda t: t.to(torch.bfloat16) if t.is_floating_point() else t)(torch.as_tensor(a))
    B, Hq, Hkv, T, C, D = (2, 32, 16, 1, 16384, 128)
    tree_mask = torch.zeros((B, T, T), dtype=float)
    for b in range(B):
        parent = torch.zeros(T, dtype=torch.int64)
        for i in range(1, T):
            parent[i] = int(torch.randint(0, i, (1,)).item())
        for i in range(T):
            j = i
            tree_mask[b, i, j] = 1.0
            while j > 0:
                j = parent[j]
                tree_mask[b, i, j] = 1.0
    return {'q': _w((lambda *s: torch.randn(*s, dtype=torch.bfloat16) * 0.8)(B, Hq, T, D)), 'k_cache': _w((lambda *s: torch.randn(*s, dtype=torch.bfloat16) * 0.8)(B, Hkv, C, D)), 'v_cache': _w((lambda *s: torch.randn(*s, dtype=torch.bfloat16) * 0.05)(B, Hkv, C, D)), 'k_tree': _w((lambda *s: torch.randn(*s, dtype=torch.bfloat16) * 0.8)(B, Hkv, T, D)), 'v_tree': _w((lambda *s: torch.randn(*s, dtype=torch.bfloat16) * 0.05)(B, Hkv, T, D)), 'tree_mask': _w(tree_mask)}

def reference(q, k_cache, v_cache, k_tree, v_tree, tree_mask):
    B, Hq, T, D = q.shape
    Hkv, C = (k_cache.shape[1], k_cache.shape[2])
    rep = Hq // Hkv
    kc = (lambda x, n, axis: torch.repeat_interleave(x, n, dim=axis))(k_cache, rep, axis=1)
    vc = (lambda x, n, axis: torch.repeat_interleave(x, n, dim=axis))(v_cache, rep, axis=1)
    kt = (lambda x, n, axis: torch.repeat_interleave(x, n, dim=axis))(k_tree, rep, axis=1)
    vt = (lambda x, n, axis: torch.repeat_interleave(x, n, dim=axis))(v_tree, rep, axis=1)
    k = torch.concatenate([kc, kt], axis=2)
    v = torch.concatenate([vc, vt], axis=2)
    scale = D ** (-0.5)
    scores = torch.einsum('bhqd,bhkd->bhqk', q, k) * scale
    ctx_mask = torch.ones((B, 1, T, C), dtype=scores.dtype)
    tm = tree_mask[:, None, :, :].clone()
    full_mask = torch.concatenate([ctx_mask, tm], axis=-1)
    scores = scores + (1.0 - full_mask) * -1000000000.0
    p = _softmax(scores, axis=-1)
    return torch.einsum('bhqk,bhkd->bhqd', p, v)
```

```asm
; @launch grid=(256,1,1) block=(256,1,1) lds=16720
.amdgcn_target "amdgcn-amd-amdhsa--gfx950"
.text
.globl standalone__tree_speculative_verify_tree_attention_over_candidate_token_tree__decode_kernel
.p2align 8
.type standalone__tree_speculative_verify_tree_attention_over_candidate_token_tree__decode_kernel,@function
standalone__tree_speculative_verify_tree_attention_over_candidate_token_tree__decode_kernel:
    s_cmp_ge_u32 s2, 256
    s_cbranch_scc1 L_end
    s_load_dwordx16 s[4:19], s[0:1], 0
    s_load_dwordx2 s[20:21], s[0:1], 64
    s_lshr_b32 s22, s2, 3
    s_and_b32 s23, s2, 7
    v_and_b32 v1, 63, v0
    v_lshlrev_b32 v1, 4, v1
    v_lshrrev_b32 v6, 6, v0
    s_nop 0
    v_readfirstlane_b32 s24, v6
    v_and_b32 v7, 15, v0
    v_lshlrev_b32 v7, 4, v7
    v_and_b32 v56, 127, v0
    v_bfe_u32 v57, v0, 7, 1
    v_lshlrev_b32 v58, 1, v56
    v_lshl_add_u32 v59, v57, 8, v58
    s_waitcnt lgkmcnt(0)
    s_mov_b32 s28, s4
    s_mov_b32 s29, s5
    s_mov_b32 s30, 16384
    s_mov_b32 s31, 0x00020000
    s_mov_b32 s32, s6
    s_mov_b32 s33, s7
    s_mov_b32 s34, 134217728
    s_mov_b32 s35, 0x00020000
    s_mov_b32 s36, s8
    s_mov_b32 s37, s9
    s_mov_b32 s38, 134217728
    s_mov_b32 s39, 0x00020000
    s_mov_b32 s40, s10
    s_mov_b32 s41, s11
    s_mov_b32 s42, 8192
    s_mov_b32 s43, 0x00020000
    s_mov_b32 s44, s12
    s_mov_b32 s45, s13
    s_mov_b32 s46, 8192
    s_mov_b32 s47, 0x00020000
    s_mov_b32 s48, s14
    s_mov_b32 s49, s15
    s_mov_b32 s50, 4
    s_mov_b32 s51, 0x00020000
    s_mov_b32 s52, s16
    s_mov_b32 s53, s17
    s_mov_b32 s54, 16384
    s_mov_b32 s55, 0x00020000
    s_mov_b32 s56, s18
    s_mov_b32 s57, s19
    s_mov_b32 s58, 256
    s_mov_b32 s59, 0x00020000
    s_mov_b32 s60, s20
    s_mov_b32 s61, s21
    s_mov_b32 s62, 8388608
    s_mov_b32 s63, 0x00020000
    s_lshl_b32 s25, s22, 9
    s_lshl_b32 s26, s22, 8
    s_lshr_b32 s27, s22, 4
    s_lshl_b32 s27, s27, 1
    v_mov_b32 v60, 0
    buffer_load_dwordx4 v[8:11], v7, s[28:31], s25 offen
    buffer_load_dwordx4 v[12:15], v7, s[28:31], s25 offen offset:256
    buffer_load_ushort v2, v59, s[28:31], s25 offen
    buffer_load_ushort v3, v58, s[40:43], s26 offen
    buffer_load_ushort v4, v58, s[44:47], s26 offen
    buffer_load_ushort v5, v60, s[48:51], s27 offen
    s_lshl_b32 s64, s22, 22
    s_mul_i32 s65, s23, 16384
    s_add_u32 s64, s64, s65
    s_lshl_b32 s65, s24, 12
    s_add_u32 s64, s64, s65
    s_mov_b32 s66, s64
    s_mov_b32 s67, s64
    s_mov_b32 s68, 0x3e0293ee
    s_mov_b32 s69, 0xffff0000
    buffer_load_dwordx4 v[64:67], v1, s[32:35], s66 offen offset:0 nt
    buffer_load_dwordx4 v[68:71], v1, s[32:35], s66 offen offset:1024 nt
    buffer_load_dwordx4 v[72:75], v1, s[32:35], s66 offen offset:2048 nt
    buffer_load_dwordx4 v[76:79], v1, s[32:35], s66 offen offset:3072 nt
    s_add_u32 s66, s66, 131072
    buffer_load_dwordx4 v[80:83], v1, s[36:39], s67 offen offset:0 nt
    buffer_load_dwordx4 v[84:87], v1, s[36:39], s67 offen offset:1024 nt
    buffer_load_dwordx4 v[88:91], v1, s[36:39], s67 offen offset:2048 nt
    buffer_load_dwordx4 v[92:95], v1, s[36:39], s67 offen offset:3072 nt
    s_add_u32 s67, s67, 131072
    buffer_load_dwordx4 v[96:99], v1, s[32:35], s66 offen offset:0 nt
    buffer_load_dwordx4 v[100:103], v1, s[32:35], s66 offen offset:1024 nt
    buffer_load_dwordx4 v[104:107], v1, s[32:35], s66 offen offset:2048 nt
    buffer_load_dwordx4 v[108:111], v1, s[32:35], s66 offen offset:3072 nt
    s_add_u32 s66, s66, 131072
    buffer_load_dwordx4 v[112:115], v1, s[36:39], s67 offen offset:0 nt
    buffer_load_dwordx4 v[116:119], v1, s[36:39], s67 offen offset:1024 nt
    buffer_load_dwordx4 v[120:123], v1, s[36:39], s67 offen offset:2048 nt
    buffer_load_dwordx4 v[124:127], v1, s[36:39], s67 offen offset:3072 nt
    s_add_u32 s67, s67, 131072
    v_mov_b32 v16, 0
    v_mov_b32 v17, 0
    v_mov_b32 v18, 0
    v_mov_b32 v19, 0
    v_mov_b32 v20, 0
    v_mov_b32 v21, 0
    v_mov_b32 v22, 0
    v_mov_b32 v23, 0
    v_mov_b32 v24, 0
    v_mov_b32 v25, 0
    v_mov_b32 v26, 0
    v_mov_b32 v27, 0
    v_mov_b32 v28, 0
    v_mov_b32 v29, 0
    v_mov_b32 v30, 0
    v_mov_b32 v31, 0
    v_mov_b32 v32, 0xf149f2ca
    v_mov_b32 v33, 0xf149f2ca
    v_mov_b32 v34, 0
    v_mov_b32 v35, 0
    s_mov_b32 s78, 15
L_loop:
    s_waitcnt vmcnt(12)
    v_dot2_f32_bf16 v36, v64, v8, 0
    v_dot2_f32_bf16 v37, v64, v12, 0
    v_dot2_f32_bf16 v38, v68, v8, 0
    v_dot2_f32_bf16 v39, v68, v12, 0
    v_dot2_f32_bf16 v40, v72, v8, 0
    v_dot2_f32_bf16 v41, v72, v12, 0
    v_dot2_f32_bf16 v42, v76, v8, 0
    v_dot2_f32_bf16 v43, v76, v12, 0
    v_dot2_f32_bf16 v36, v65, v9, v36
    v_dot2_f32_bf16 v37, v65, v13, v37
    v_dot2_f32_bf16 v38, v69, v9, v38
    v_dot2_f32_bf16 v39, v69, v13, v39
    v_dot2_f32_bf16 v40, v73, v9, v40
    v_dot2_f32_bf16 v41, v73, v13, v41
    v_dot2_f32_bf16 v42, v77, v9, v42
    v_dot2_f32_bf16 v43, v77, v13, v43
    v_dot2_f32_bf16 v36, v66, v10, v36
    v_dot2_f32_bf16 v37, v66, v14, v37
    v_dot2_f32_bf16 v38, v70, v10, v38
    v_dot2_f32_bf16 v39, v70, v14, v39
    v_dot2_f32_bf16 v40, v74, v10, v40
    v_dot2_f32_bf16 v41, v74, v14, v41
    v_dot2_f32_bf16 v42, v78, v10, v42
    v_dot2_f32_bf16 v43, v78, v14, v43
    v_dot2_f32_bf16 v36, v67, v11, v36
    v_dot2_f32_bf16 v37, v67, v15, v37
    v_dot2_f32_bf16 v38, v71, v11, v38
    v_dot2_f32_bf16 v39, v71, v15, v39
    v_dot2_f32_bf16 v40, v75, v11, v40
    v_dot2_f32_bf16 v41, v75, v15, v41
    v_dot2_f32_bf16 v42, v79, v11, v42
    v_dot2_f32_bf16 v43, v79, v15, v43
    buffer_load_dwordx4 v[64:67], v1, s[32:35], s66 offen offset:0 nt
    buffer_load_dwordx4 v[68:71], v1, s[32:35], s66 offen offset:1024 nt
    buffer_load_dwordx4 v[72:75], v1, s[32:35], s66 offen offset:2048 nt
    buffer_load_dwordx4 v[76:79], v1, s[32:35], s66 offen offset:3072 nt
    s_add_u32 s66, s66, 131072
    v_add_f32_dpp v36, v36, v36 row_ror:8 row_mask:0xf bank_mask:0xf
    v_add_f32_dpp v37, v37, v37 row_ror:8 row_mask:0xf bank_mask:0xf
    v_add_f32_dpp v38, v38, v38 row_ror:8 row_mask:0xf bank_mask:0xf
    v_add_f32_dpp v39, v39, v39 row_ror:8 row_mask:0xf bank_mask:0xf
    v_add_f32_dpp v40, v40, v40 row_ror:8 row_mask:0xf bank_mask:0xf
    v_add_f32_dpp v41, v41, v41 row_ror:8 row_mask:0xf bank_mask:0xf
    v_add_f32_dpp v42, v42, v42 row_ror:8 row_mask:0xf bank_mask:0xf
    v_add_f32_dpp v43, v43, v43 row_ror:8 row_mask:0xf bank_mask:0xf
    v_add_f32_dpp v36, v36, v36 row_ror:4 row_mask:0xf bank_mask:0xf
    v_add_f32_dpp v37, v37, v37 row_ror:4 row_mask:0xf bank_mask:0xf
    v_add_f32_dpp v38, v38, v38 row_ror:4 row_mask:0xf bank_mask:0xf
    v_add_f32_dpp v39, v39, v39 row_ror:4 row_mask:0xf bank_mask:0xf
    v_add_f32_dpp v40, v40, v40 row_ror:4 row_mask:0xf bank_mask:0xf
    v_add_f32_dpp v41, v41, v41 row_ror:4 row_mask:0xf bank_mask:0xf
    v_add_f32_dpp v42, v42, v42 row_ror:4 row_mask:0xf bank_mask:0xf
    v_add_f32_dpp v43, v43, v43 row_ror:4 row_mask:0xf bank_mask:0xf
    v_add_f32_dpp v36, v36, v36 row_ror:2 row_mask:0xf bank_mask:0xf
    v_add_f32_dpp v37, v37, v37 row_ror:2 row_mask:0xf bank_mask:0xf
    v_add_f32_dpp v38, v38, v38 row_ror:2 row_mask:0xf bank_mask:0xf
    v_add_f32_dpp v39, v39, v39 row_ror:2 row_mask:0xf bank_mask:0xf
    v_add_f32_dpp v40, v40, v40 row_ror:2 row_mask:0xf bank_mask:0xf
    v_add_f32_dpp v41, v41, v41 row_ror:2 row_mask:0xf bank_mask:0xf
    v_add_f32_dpp v42, v42, v42 row_ror:2 row_mask:0xf bank_mask:0xf
    v_add_f32_dpp v43, v43, v43 row_ror:2 row_mask:0xf bank_mask:0xf
    v_add_f32_dpp v36, v36, v36 row_ror:1 row_mask:0xf bank_mask:0xf
    v_add_f32_dpp v37, v37, v37 row_ror:1 row_mask:0xf bank_mask:0xf
    v_add_f32_dpp v38, v38, v38 row_ror:1 row_mask:0xf bank_mask:0xf
    v_add_f32_dpp v39, v39, v39 row_ror:1 row_mask:0xf bank_mask:0xf
    v_add_f32_dpp v40, v40, v40 row_ror:1 row_mask:0xf bank_mask:0xf
    v_add_f32_dpp v41, v41, v41 row_ror:1 row_mask:0xf bank_mask:0xf
    v_add_f32_dpp v42, v42, v42 row_ror:1 row_mask:0xf bank_mask:0xf
    v_add_f32_dpp v43, v43, v43 row_ror:1 row_mask:0xf bank_mask:0xf
    v_mul_f32 v36, s68, v36
    v_mul_f32 v37, s68, v37
    v_mul_f32 v38, s68, v38
    v_mul_f32 v39, s68, v39
    v_mul_f32 v40, s68, v40
    v_mul_f32 v41, s68, v41
    v_mul_f32 v42, s68, v42
    v_mul_f32 v43, s68, v43
    v_max3_f32 v52, v36, v38, v40
    v_max3_f32 v53, v37, v39, v41
    v_max3_f32 v52, v52, v42, v32
    v_max3_f32 v53, v53, v43, v33
    v_sub_f32 v54, v32, v52
    v_sub_f32 v55, v33, v53
    v_sub_f32 v36, v36, v52
    v_sub_f32 v37, v37, v53
    v_sub_f32 v38, v38, v52
    v_sub_f32 v39, v39, v53
    v_sub_f32 v40, v40, v52
    v_sub_f32 v41, v41, v53
    v_sub_f32 v42, v42, v52
    v_sub_f32 v43, v43, v53
    v_exp_f32 v54, v54
    v_exp_f32 v55, v55
    v_exp_f32 v36, v36
    v_exp_f32 v37, v37
    v_exp_f32 v38, v38
    v_exp_f32 v39, v39
    v_exp_f32 v40, v40
    v_exp_f32 v41, v41
    v_exp_f32 v42, v42
    v_exp_f32 v43, v43
    v_mov_b32 v32, v52
    v_mov_b32 v33, v53
    v_fma_f32 v34, v34, v54, v36
    v_fma_f32 v35, v35, v55, v37
    v_add_f32 v34, v34, v38
    v_add_f32 v35, v35, v39
    v_add_f32 v34, v34, v40
    v_add_f32 v35, v35, v41
    v_add_f32 v34, v34, v42
    v_add_f32 v35, v35, v43
    v_mul_f32 v16, v54, v16
    v_mul_f32 v17, v54, v17
    v_mul_f32 v18, v54, v18
    v_mul_f32 v19, v54, v19
    v_mul_f32 v20, v54, v20
    v_mul_f32 v21, v54, v21
    v_mul_f32 v22, v54, v22
    v_mul_f32 v23, v54, v23
    v_mul_f32 v24, v55, v24
    v_mul_f32 v25, v55, v25
    v_mul_f32 v26, v55, v26
    v_mul_f32 v27, v55, v27
    v_mul_f32 v28, v55, v28
    v_mul_f32 v29, v55, v29
    v_mul_f32 v30, v55, v30
    v_mul_f32 v31, v55, v31
    s_waitcnt vmcnt(12)
    v_lshlrev_b32 v44, 16, v80
    v_and_b32 v45, s69, v80
    v_lshlrev_b32 v46, 16, v81
    v_and_b32 v47, s69, v81
    v_lshlrev_b32 v48, 16, v82
    v_and_b32 v49, s69, v82
    v_lshlrev_b32 v50, 16, v83
    v_and_b32 v51, s69, v83
    v_fmac_f32 v16, v36, v44
    v_fmac_f32 v17, v36, v45
    v_fmac_f32 v18, v36, v46
    v_fmac_f32 v19, v36, v47
    v_fmac_f32 v20, v36, v48
    v_fmac_f32 v21, v36, v49
    v_fmac_f32 v22, v36, v50
    v_fmac_f32 v23, v36, v51
    v_fmac_f32 v24, v37, v44
    v_fmac_f32 v25, v37, v45
    v_fmac_f32 v26, v37, v46
    v_fmac_f32 v27, v37, v47
    v_fmac_f32 v28, v37, v48
    v_fmac_f32 v29, v37, v49
    v_fmac_f32 v30, v37, v50
    v_fmac_f32 v31, v37, v51
    v_lshlrev_b32 v44, 16, v84
    v_and_b32 v45, s69, v84
    v_lshlrev_b32 v46, 16, v85
    v_and_b32 v47, s69, v85
    v_lshlrev_b32 v48, 16, v86
    v_and_b32 v49, s69, v86
    v_lshlrev_b32 v50, 16, v87
    v_and_b32 v51, s69, v87
    v_fmac_f32 v16, v38, v44
    v_fmac_f32 v17, v38, v45
    v_fmac_f32 v18, v38, v46
    v_fmac_f32 v19, v38, v47
    v_fmac_f32 v20, v38, v48
    v_fmac_f32 v21, v38, v49
    v_fmac_f32 v22, v38, v50
    v_fmac_f32 v23, v38, v51
    v_fmac_f32 v24, v39, v44
    v_fmac_f32 v25, v39, v45
    v_fmac_f32 v26, v39, v46
    v_fmac_f32 v27, v39, v47
    v_fmac_f32 v28, v39, v48
    v_fmac_f32 v29, v39, v49
    v_fmac_f32 v30, v39, v50
    v_fmac_f32 v31, v39, v51
    v_lshlrev_b32 v44, 16, v88
    v_and_b32 v45, s69, v88
    v_lshlrev_b32 v46, 16, v89
    v_and_b32 v47, s69, v89
    v_lshlrev_b32 v48, 16, v90
    v_and_b32 v49, s69, v90
    v_lshlrev_b32 v50, 16, v91
    v_and_b32 v51, s69, v91
    v_fmac_f32 v16, v40, v44
    v_fmac_f32 v17, v40, v45
    v_fmac_f32 v18, v40, v46
    v_fmac_f32 v19, v40, v47
    v_fmac_f32 v20, v40, v48
    v_fmac_f32 v21, v40, v49
    v_fmac_f32 v22, v40, v50
    v_fmac_f32 v23, v40, v51
    v_fmac_f32 v24, v41, v44
    v_fmac_f32 v25, v41, v45
    v_fmac_f32 v26, v41, v46
    v_fmac_f32 v27, v41, v47
    v_fmac_f32 v28, v41, v48
    v_fmac_f32 v29, v41, v49
    v_fmac_f32 v30, v41, v50
    v_fmac_f32 v31, v41, v51
    v_lshlrev_b32 v44, 16, v92
    v_and_b32 v45, s69, v92
    v_lshlrev_b32 v46, 16, v93
    v_and_b32 v47, s69, v93
    v_lshlrev_b32 v48, 16, v94
    v_and_b32 v49, s69, v94
    v_lshlrev_b32 v50, 16, v95
    v_and_b32 v51, s69, v95
    v_fmac_f32 v16, v42, v44
    v_fmac_f32 v17, v42, v45
    v_fmac_f32 v18, v42, v46
    v_fmac_f32 v19, v42, v47
    v_fmac_f32 v20, v42, v48
    v_fmac_f32 v21, v42, v49
    v_fmac_f32 v22, v42, v50
    v_fmac_f32 v23, v42, v51
    v_fmac_f32 v24, v43, v44
    v_fmac_f32 v25, v43, v45
    v_fmac_f32 v26, v43, v46
    v_fmac_f32 v27, v43, v47
    v_fmac_f32 v28, v43, v48
    v_fmac_f32 v29, v43, v49
    v_fmac_f32 v30, v43, v50
    v_fmac_f32 v31, v43, v51
    buffer_load_dwordx4 v[80:83], v1, s[36:39], s67 offen offset:0 nt
    buffer_load_dwordx4 v[84:87], v1, s[36:39], s67 offen offset:1024 nt
    buffer_load_dwordx4 v[88:91], v1, s[36:39], s67 offen offset:2048 nt
    buffer_load_dwordx4 v[92:95], v1, s[36:39], s67 offen offset:3072 nt
    s_add_u32 s67, s67, 131072
    s_waitcnt vmcnt(12)
    v_dot2_f32_bf16 v36, v96, v8, 0
    v_dot2_f32_bf16 v37, v96, v12, 0
    v_dot2_f32_bf16 v38, v100, v8, 0
    v_dot2_f32_bf16 v39, v100, v12, 0
    v_dot2_f32_bf16 v40, v104, v8, 0
    v_dot2_f32_bf16 v41, v104, v12, 0
    v_dot2_f32_bf16 v42, v108, v8, 0
    v_dot2_f32_bf16 v43, v108, v12, 0
    v_dot2_f32_bf16 v36, v97, v9, v36
    v_dot2_f32_bf16 v37, v97, v13, v37
    v_dot2_f32_bf16 v38, v101, v9, v38
    v_dot2_f32_bf16 v39, v101, v13, v39
    v_dot2_f32_bf16 v40, v105, v9, v40
    v_dot2_f32_bf16 v41, v105, v13, v41
    v_dot2_f32_bf16 v42, v109, v9, v42
    v_dot2_f32_bf16 v43, v109, v13, v43
    v_dot2_f32_bf16 v36, v98, v10, v36
    v_dot2_f32_bf16 v37, v98, v14, v37
    v_dot2_f32_bf16 v38, v102, v10, v38
    v_dot2_f32_bf16 v39, v102, v14, v39
    v_dot2_f32_bf16 v40, v106, v10, v40
    v_dot2_f32_bf16 v41, v106, v14, v41
    v_dot2_f32_bf16 v42, v110, v10, v42
    v_dot2_f32_bf16 v43, v110, v14, v43
    v_dot2_f32_bf16 v36, v99, v11, v36
    v_dot2_f32_bf16 v37, v99, v15, v37
    v_dot2_f32_bf16 v38, v103, v11, v38
    v_dot2_f32_bf16 v39, v103, v15, v39
    v_dot2_f32_bf16 v40, v107, v11, v40
    v_dot2_f32_bf16 v41, v107, v15, v41
    v_dot2_f32_bf16 v42, v111, v11, v42
    v_dot2_f32_bf16 v43, v111, v15, v43
    buffer_load_dwordx4 v[96:99], v1, s[32:35], s66 offen offset:0 nt
    buffer_load_dwordx4 v[100:103], v1, s[32:35], s66 offen offset:1024 nt
    buffer_load_dwordx4 v[104:107], v1, s[32:35], s66 offen offset:2048 nt
    buffer_load_dwordx4 v[108:111], v1, s[32:35], s66 offen offset:3072 nt
    s_add_u32 s66, s66, 131072
    v_add_f32_dpp v36, v36, v36 row_ror:8 row_mask:0xf bank_mask:0xf
    v_add_f32_dpp v37, v37, v37 row_ror:8 row_mask:0xf bank_mask:0xf
    v_add_f32_dpp v38, v38, v38 row_ror:8 row_mask:0xf bank_mask:0xf
    v_add_f32_dpp v39, v39, v39 row_ror:8 row_mask:0xf bank_mask:0xf
    v_add_f32_dpp v40, v40, v40 row_ror:8 row_mask:0xf bank_mask:0xf
    v_add_f32_dpp v41, v41, v41 row_ror:8 row_mask:0xf bank_mask:0xf
    v_add_f32_dpp v42, v42, v42 row_ror:8 row_mask:0xf bank_mask:0xf
    v_add_f32_dpp v43, v43, v43 row_ror:8 row_mask:0xf bank_mask:0xf
    v_add_f32_dpp v36, v36, v36 row_ror:4 row_mask:0xf bank_mask:0xf
    v_add_f32_dpp v37, v37, v37 row_ror:4 row_mask:0xf bank_mask:0xf
    v_add_f32_dpp v38, v38, v38 row_ror:4 row_mask:0xf bank_mask:0xf
    v_add_f32_dpp v39, v39, v39 row_ror:4 row_mask:0xf bank_mask:0xf
    v_add_f32_dpp v40, v40, v40 row_ror:4 row_mask:0xf bank_mask:0xf
    v_add_f32_dpp v41, v41, v41 row_ror:4 row_mask:0xf bank_mask:0xf
    v_add_f32_dpp v42, v42, v42 row_ror:4 row_mask:0xf bank_mask:0xf
    v_add_f32_dpp v43, v43, v43 row_ror:4 row_mask:0xf bank_mask:0xf
    v_add_f32_dpp v36, v36, v36 row_ror:2 row_mask:0xf bank_mask:0xf
    v_add_f32_dpp v37, v37, v37 row_ror:2 row_mask:0xf bank_mask:0xf
    v_add_f32_dpp v38, v38, v38 row_ror:2 row_mask:0xf bank_mask:0xf
    v_add_f32_dpp v39, v39, v39 row_ror:2 row_mask:0xf bank_mask:0xf
    v_add_f32_dpp v40, v40, v40 row_ror:2 row_mask:0xf bank_mask:0xf
    v_add_f32_dpp v41, v41, v41 row_ror:2 row_mask:0xf bank_mask:0xf
    v_add_f32_dpp v42, v42, v42 row_ror:2 row_mask:0xf bank_mask:0xf
    v_add_f32_dpp v43, v43, v43 row_ror:2 row_mask:0xf bank_mask:0xf
    v_add_f32_dpp v36, v36, v36 row_ror:1 row_mask:0xf bank_mask:0xf
    v_add_f32_dpp v37, v37, v37 row_ror:1 row_mask:0xf bank_mask:0xf
    v_add_f32_dpp v38, v38, v38 row_ror:1 row_mask:0xf bank_mask:0xf
    v_add_f32_dpp v39, v39, v39 row_ror:1 row_mask:0xf bank_mask:0xf
    v_add_f32_dpp v40, v40, v40 row_ror:1 row_mask:0xf bank_mask:0xf
    v_add_f32_dpp v41, v41, v41 row_ror:1 row_mask:0xf bank_mask:0xf
    v_add_f32_dpp v42, v42, v42 row_ror:1 row_mask:0xf bank_mask:0xf
    v_add_f32_dpp v43, v43, v43 row_ror:1 row_mask:0xf bank_mask:0xf
    v_mul_f32 v36, s68, v36
    v_mul_f32 v37, s68, v37
    v_mul_f32 v38, s68, v38
    v_mul_f32 v39, s68, v39
    v_mul_f32 v40, s68, v40
    v_mul_f32 v41, s68, v41
    v_mul_f32 v42, s68, v42
    v_mul_f32 v43, s68, v43
    v_max3_f32 v52, v36, v38, v40
    v_max3_f32 v53, v37, v39, v41
    v_max3_f32 v52, v52, v42, v32
    v_max3_f32 v53, v53, v43, v33
    v_sub_f32 v54, v32, v52
    v_sub_f32 v55, v33, v53
    v_sub_f32 v36, v36, v52
    v_sub_f32 v37, v37, v53
    v_sub_f32 v38, v38, v52
    v_sub_f32 v39, v39, v53
    v_sub_f32 v40, v40, v52
    v_sub_f32 v41, v41, v53
    v_sub_f32 v42, v42, v52
    v_sub_f32 v43, v43, v53
    v_exp_f32 v54, v54
    v_exp_f32 v55, v55
    v_exp_f32 v36, v36
    v_exp_f32 v37, v37
    v_exp_f32 v38, v38
    v_exp_f32 v39, v39
    v_exp_f32 v40, v40
    v_exp_f32 v41, v41
    v_exp_f32 v42, v42
    v_exp_f32 v43, v43
    v_mov_b32 v32, v52
    v_mov_b32 v33, v53
    v_fma_f32 v34, v34, v54, v36
    v_fma_f32 v35, v35, v55, v37
    v_add_f32 v34, v34, v38
    v_add_f32 v35, v35, v39
    v_add_f32 v34, v34, v40
    v_add_f32 v35, v35, v41
    v_add_f32 v34, v34, v42
    v_add_f32 v35, v35, v43
    v_mul_f32 v16, v54, v16
    v_mul_f32 v17, v54, v17
    v_mul_f32 v18, v54, v18
    v_mul_f32 v19, v54, v19
    v_mul_f32 v20, v54, v20
    v_mul_f32 v21, v54, v21
    v_mul_f32 v22, v54, v22
    v_mul_f32 v23, v54, v23
    v_mul_f32 v24, v55, v24
    v_mul_f32 v25, v55, v25
    v_mul_f32 v26, v55, v26
    v_mul_f32 v27, v55, v27
    v_mul_f32 v28, v55, v28
    v_mul_f32 v29, v55, v29
    v_mul_f32 v30, v55, v30
    v_mul_f32 v31, v55, v31
    s_waitcnt vmcnt(12)
    v_lshlrev_b32 v44, 16, v112
    v_and_b32 v45, s69, v112
    v_lshlrev_b32 v46, 16, v113
    v_and_b32 v47, s69, v113
    v_lshlrev_b32 v48, 16, v114
    v_and_b32 v49, s69, v114
    v_lshlrev_b32 v50, 16, v115
    v_and_b32 v51, s69, v115
    v_fmac_f32 v16, v36, v44
    v_fmac_f32 v17, v36, v45
    v_fmac_f32 v18, v36, v46
    v_fmac_f32 v19, v36, v47
    v_fmac_f32 v20, v36, v48
    v_fmac_f32 v21, v36, v49
    v_fmac_f32 v22, v36, v50
    v_fmac_f32 v23, v36, v51
    v_fmac_f32 v24, v37, v44
    v_fmac_f32 v25, v37, v45
    v_fmac_f32 v26, v37, v46
    v_fmac_f32 v27, v37, v47
    v_fmac_f32 v28, v37, v48
    v_fmac_f32 v29, v37, v49
    v_fmac_f32 v30, v37, v50
    v_fmac_f32 v31, v37, v51
    v_lshlrev_b32 v44, 16, v116
    v_and_b32 v45, s69, v116
    v_lshlrev_b32 v46, 16, v117
    v_and_b32 v47, s69, v117
    v_lshlrev_b32 v48, 16, v118
    v_and_b32 v49, s69, v118
    v_lshlrev_b32 v50, 16, v119
    v_and_b32 v51, s69, v119
    v_fmac_f32 v16, v38, v44
    v_fmac_f32 v17, v38, v45
    v_fmac_f32 v18, v38, v46
    v_fmac_f32 v19, v38, v47
    v_fmac_f32 v20, v38, v48
    v_fmac_f32 v21, v38, v49
    v_fmac_f32 v22, v38, v50
    v_fmac_f32 v23, v38, v51
    v_fmac_f32 v24, v39, v44
    v_fmac_f32 v25, v39, v45
    v_fmac_f32 v26, v39, v46
    v_fmac_f32 v27, v39, v47
    v_fmac_f32 v28, v39, v48
    v_fmac_f32 v29, v39, v49
    v_fmac_f32 v30, v39, v50
    v_fmac_f32 v31, v39, v51
    v_lshlrev_b32 v44, 16, v120
    v_and_b32 v45, s69, v120
    v_lshlrev_b32 v46, 16, v121
    v_and_b32 v47, s69, v121
    v_lshlrev_b32 v48, 16, v122
    v_and_b32 v49, s69, v122
    v_lshlrev_b32 v50, 16, v123
    v_and_b32 v51, s69, v123
    v_fmac_f32 v16, v40, v44
    v_fmac_f32 v17, v40, v45
    v_fmac_f32 v18, v40, v46
    v_fmac_f32 v19, v40, v47
    v_fmac_f32 v20, v40, v48
    v_fmac_f32 v21, v40, v49
    v_fmac_f32 v22, v40, v50
    v_fmac_f32 v23, v40, v51
    v_fmac_f32 v24, v41, v44
    v_fmac_f32 v25, v41, v45
    v_fmac_f32 v26, v41, v46
    v_fmac_f32 v27, v41, v47
    v_fmac_f32 v28, v41, v48
    v_fmac_f32 v29, v41, v49
    v_fmac_f32 v30, v41, v50
    v_fmac_f32 v31, v41, v51
    v_lshlrev_b32 v44, 16, v124
    v_and_b32 v45, s69, v124
    v_lshlrev_b32 v46, 16, v125
    v_and_b32 v47, s69, v125
    v_lshlrev_b32 v48, 16, v126
    v_and_b32 v49, s69, v126
    v_lshlrev_b32 v50, 16, v127
    v_and_b32 v51, s69, v127
    v_fmac_f32 v16, v42, v44
    v_fmac_f32 v17, v42, v45
    v_fmac_f32 v18, v42, v46
    v_fmac_f32 v19, v42, v47
    v_fmac_f32 v20, v42, v48
    v_fmac_f32 v21, v42, v49
    v_fmac_f32 v22, v42, v50
    v_fmac_f32 v23, v42, v51
    v_fmac_f32 v24, v43, v44
    v_fmac_f32 v25, v43, v45
    v_fmac_f32 v26, v43, v46
    v_fmac_f32 v27, v43, v47
    v_fmac_f32 v28, v43, v48
    v_fmac_f32 v29, v43, v49
    v_fmac_f32 v30, v43, v50
    v_fmac_f32 v31, v43, v51
    buffer_load_dwordx4 v[112:115], v1, s[36:39], s67 offen offset:0 nt
    buffer_load_dwordx4 v[116:119], v1, s[36:39], s67 offen offset:1024 nt
    buffer_load_dwordx4 v[120:123], v1, s[36:39], s67 offen offset:2048 nt
    buffer_load_dwordx4 v[124:127], v1, s[36:39], s67 offen offset:3072 nt
    s_add_u32 s67, s67, 131072
    s_sub_u32 s78, s78, 1
    s_cmp_lg_u32 s78, 0
    s_cbranch_scc1 L_loop
    s_waitcnt vmcnt(12)
    v_dot2_f32_bf16 v36, v64, v8, 0
    v_dot2_f32_bf16 v37, v64, v12, 0
    v_dot2_f32_bf16 v38, v68, v8, 0
    v_dot2_f32_bf16 v39, v68, v12, 0
    v_dot2_f32_bf16 v40, v72, v8, 0
    v_dot2_f32_bf16 v41, v72, v12, 0
    v_dot2_f32_bf16 v42, v76, v8, 0
    v_dot2_f32_bf16 v43, v76, v12, 0
    v_dot2_f32_bf16 v36, v65, v9, v36
    v_dot2_f32_bf16 v37, v65, v13, v37
    v_dot2_f32_bf16 v38, v69, v9, v38
    v_dot2_f32_bf16 v39, v69, v13, v39
    v_dot2_f32_bf16 v40, v73, v9, v40
    v_dot2_f32_bf16 v41, v73, v13, v41
    v_dot2_f32_bf16 v42, v77, v9, v42
    v_dot2_f32_bf16 v43, v77, v13, v43
    v_dot2_f32_bf16 v36, v66, v10, v36
    v_dot2_f32_bf16 v37, v66, v14, v37
    v_dot2_f32_bf16 v38, v70, v10, v38
    v_dot2_f32_bf16 v39, v70, v14, v39
    v_dot2_f32_bf16 v40, v74, v10, v40
    v_dot2_f32_bf16 v41, v74, v14, v41
    v_dot2_f32_bf16 v42, v78, v10, v42
    v_dot2_f32_bf16 v43, v78, v14, v43
    v_dot2_f32_bf16 v36, v67, v11, v36
    v_dot2_f32_bf16 v37, v67, v15, v37
    v_dot2_f32_bf16 v38, v71, v11, v38
    v_dot2_f32_bf16 v39, v71, v15, v39
    v_dot2_f32_bf16 v40, v75, v11, v40
    v_dot2_f32_bf16 v41, v75, v15, v41
    v_dot2_f32_bf16 v42, v79, v11, v42
    v_dot2_f32_bf16 v43, v79, v15, v43
    v_add_f32_dpp v36, v36, v36 row_ror:8 row_mask:0xf bank_mask:0xf
    v_add_f32_dpp v37, v37, v37 row_ror:8 row_mask:0xf bank_mask:0xf
    v_add_f32_dpp v38, v38, v38 row_ror:8 row_mask:0xf bank_mask:0xf
    v_add_f32_dpp v39, v39, v39 row_ror:8 row_mask:0xf bank_mask:0xf
    v_add_f32_dpp v40, v40, v40 row_ror:8 row_mask:0xf bank_mask:0xf
    v_add_f32_dpp v41, v41, v41 row_ror:8 row_mask:0xf bank_mask:0xf
    v_add_f32_dpp v42, v42, v42 row_ror:8 row_mask:0xf bank_mask:0xf
    v_add_f32_dpp v43, v43, v43 row_ror:8 row_mask:0xf bank_mask:0xf
    v_add_f32_dpp v36, v36, v36 row_ror:4 row_mask:0xf bank_mask:0xf
    v_add_f32_dpp v37, v37, v37 row_ror:4 row_mask:0xf bank_mask:0xf
    v_add_f32_dpp v38, v38, v38 row_ror:4 row_mask:0xf bank_mask:0xf
    v_add_f32_dpp v39, v39, v39 row_ror:4 row_mask:0xf bank_mask:0xf
    v_add_f32_dpp v40, v40, v40 row_ror:4 row_mask:0xf bank_mask:0xf
    v_add_f32_dpp v41, v41, v41 row_ror:4 row_mask:0xf bank_mask:0xf
    v_add_f32_dpp v42, v42, v42 row_ror:4 row_mask:0xf bank_mask:0xf
    v_add_f32_dpp v43, v43, v43 row_ror:4 row_mask:0xf bank_mask:0xf
    v_add_f32_dpp v36, v36, v36 row_ror:2 row_mask:0xf bank_mask:0xf
    v_add_f32_dpp v37, v37, v37 row_ror:2 row_mask:0xf bank_mask:0xf
    v_add_f32_dpp v38, v38, v38 row_ror:2 row_mask:0xf bank_mask:0xf
    v_add_f32_dpp v39, v39, v39 row_ror:2 row_mask:0xf bank_mask:0xf
    v_add_f32_dpp v40, v40, v40 row_ror:2 row_mask:0xf bank_mask:0xf
    v_add_f32_dpp v41, v41, v41 row_ror:2 row_mask:0xf bank_mask:0xf
    v_add_f32_dpp v42, v42, v42 row_ror:2 row_mask:0xf bank_mask:0xf
    v_add_f32_dpp v43, v43, v43 row_ror:2 row_mask:0xf bank_mask:0xf
    v_add_f32_dpp v36, v36, v36 row_ror:1 row_mask:0xf bank_mask:0xf
    v_add_f32_dpp v37, v37, v37 row_ror:1 row_mask:0xf bank_mask:0xf
    v_add_f32_dpp v38, v38, v38 row_ror:1 row_mask:0xf bank_mask:0xf
    v_add_f32_dpp v39, v39, v39 row_ror:1 row_mask:0xf bank_mask:0xf
    v_add_f32_dpp v40, v40, v40 row_ror:1 row_mask:0xf bank_mask:0xf
    v_add_f32_dpp v41, v41, v41 row_ror:1 row_mask:0xf bank_mask:0xf
    v_add_f32_dpp v42, v42, v42 row_ror:1 row_mask:0xf bank_mask:0xf
    v_add_f32_dpp v43, v43, v43 row_ror:1 row_mask:0xf bank_mask:0xf
    v_mul_f32 v36, s68, v36
    v_mul_f32 v37, s68, v37
    v_mul_f32 v38, s68, v38
    v_mul_f32 v39, s68, v39
    v_mul_f32 v40, s68, v40
    v_mul_f32 v41, s68, v41
    v_mul_f32 v42, s68, v42
    v_mul_f32 v43, s68, v43
    v_max3_f32 v52, v36, v38, v40
    v_max3_f32 v53, v37, v39, v41
    v_max3_f32 v52, v52, v42, v32
    v_max3_f32 v53, v53, v43, v33
    v_sub_f32 v54, v32, v52
    v_sub_f32 v55, v33, v53
    v_sub_f32 v36, v36, v52
    v_sub_f32 v37, v37, v53
    v_sub_f32 v38, v38, v52
    v_sub_f32 v39, v39, v53
    v_sub_f32 v40, v40, v52
    v_sub_f32 v41, v41, v53
    v_sub_f32 v42, v42, v52
    v_sub_f32 v43, v43, v53
    v_exp_f32 v54, v54
    v_exp_f32 v55, v55
    v_exp_f32 v36, v36
    v_exp_f32 v37, v37
    v_exp_f32 v38, v38
    v_exp_f32 v39, v39
    v_exp_f32 v40, v40
    v_exp_f32 v41, v41
    v_exp_f32 v42, v42
    v_exp_f32 v43, v43
    v_mov_b32 v32, v52
    v_mov_b32 v33, v53
    v_fma_f32 v34, v34, v54, v36
    v_fma_f32 v35, v35, v55, v37
    v_add_f32 v34, v34, v38
    v_add_f32 v35, v35, v39
    v_add_f32 v34, v34, v40
    v_add_f32 v35, v35, v41
    v_add_f32 v34, v34, v42
    v_add_f32 v35, v35, v43
    v_mul_f32 v16, v54, v16
    v_mul_f32 v17, v54, v17
    v_mul_f32 v18, v54, v18
    v_mul_f32 v19, v54, v19
    v_mul_f32 v20, v54, v20
    v_mul_f32 v21, v54, v21
    v_mul_f32 v22, v54, v22
    v_mul_f32 v23, v54, v23
    v_mul_f32 v24, v55, v24
    v_mul_f32 v25, v55, v25
    v_mul_f32 v26, v55, v26
    v_mul_f32 v27, v55, v27
    v_mul_f32 v28, v55, v28
    v_mul_f32 v29, v55, v29
    v_mul_f32 v30, v55, v30
    v_mul_f32 v31, v55, v31
    s_waitcnt vmcnt(8)
    v_lshlrev_b32 v44, 16, v80
    v_and_b32 v45, s69, v80
    v_lshlrev_b32 v46, 16, v81
    v_and_b32 v47, s69, v81
    v_lshlrev_b32 v48, 16, v82
    v_and_b32 v49, s69, v82
    v_lshlrev_b32 v50, 16, v83
    v_and_b32 v51, s69, v83
    v_fmac_f32 v16, v36, v44
    v_fmac_f32 v17, v36, v45
    v_fmac_f32 v18, v36, v46
    v_fmac_f32 v19, v36, v47
    v_fmac_f32 v20, v36, v48
    v_fmac_f32 v21, v36, v49
    v_fmac_f32 v22, v36, v50
    v_fmac_f32 v23, v36, v51
    v_fmac_f32 v24, v37, v44
    v_fmac_f32 v25, v37, v45
    v_fmac_f32 v26, v37, v46
    v_fmac_f32 v27, v37, v47
    v_fmac_f32 v28, v37, v48
    v_fmac_f32 v29, v37, v49
    v_fmac_f32 v30, v37, v50
    v_fmac_f32 v31, v37, v51
    v_lshlrev_b32 v44, 16, v84
    v_and_b32 v45, s69, v84
    v_lshlrev_b32 v46, 16, v85
    v_and_b32 v47, s69, v85
    v_lshlrev_b32 v48, 16, v86
    v_and_b32 v49, s69, v86
    v_lshlrev_b32 v50, 16, v87
    v_and_b32 v51, s69, v87
    v_fmac_f32 v16, v38, v44
    v_fmac_f32 v17, v38, v45
    v_fmac_f32 v18, v38, v46
    v_fmac_f32 v19, v38, v47
    v_fmac_f32 v20, v38, v48
    v_fmac_f32 v21, v38, v49
    v_fmac_f32 v22, v38, v50
    v_fmac_f32 v23, v38, v51
    v_fmac_f32 v24, v39, v44
    v_fmac_f32 v25, v39, v45
    v_fmac_f32 v26, v39, v46
    v_fmac_f32 v27, v39, v47
    v_fmac_f32 v28, v39, v48
    v_fmac_f32 v29, v39, v49
    v_fmac_f32 v30, v39, v50
    v_fmac_f32 v31, v39, v51
    v_lshlrev_b32 v44, 16, v88
    v_and_b32 v45, s69, v88
    v_lshlrev_b32 v46, 16, v89
    v_and_b32 v47, s69, v89
    v_lshlrev_b32 v48, 16, v90
    v_and_b32 v49, s69, v90
    v_lshlrev_b32 v50, 16, v91
    v_and_b32 v51, s69, v91
    v_fmac_f32 v16, v40, v44
    v_fmac_f32 v17, v40, v45
    v_fmac_f32 v18, v40, v46
    v_fmac_f32 v19, v40, v47
    v_fmac_f32 v20, v40, v48
    v_fmac_f32 v21, v40, v49
    v_fmac_f32 v22, v40, v50
    v_fmac_f32 v23, v40, v51
    v_fmac_f32 v24, v41, v44
    v_fmac_f32 v25, v41, v45
    v_fmac_f32 v26, v41, v46
    v_fmac_f32 v27, v41, v47
    v_fmac_f32 v28, v41, v48
    v_fmac_f32 v29, v41, v49
    v_fmac_f32 v30, v41, v50
    v_fmac_f32 v31, v41, v51
    v_lshlrev_b32 v44, 16, v92
    v_and_b32 v45, s69, v92
    v_lshlrev_b32 v46, 16, v93
    v_and_b32 v47, s69, v93
    v_lshlrev_b32 v48, 16, v94
    v_and_b32 v49, s69, v94
    v_lshlrev_b32 v50, 16, v95
    v_and_b32 v51, s69, v95
    v_fmac_f32 v16, v42, v44
    v_fmac_f32 v17, v42, v45
    v_fmac_f32 v18, v42, v46
    v_fmac_f32 v19, v42, v47
    v_fmac_f32 v20, v42, v48
    v_fmac_f32 v21, v42, v49
    v_fmac_f32 v22, v42, v50
    v_fmac_f32 v23, v42, v51
    v_fmac_f32 v24, v43, v44
    v_fmac_f32 v25, v43, v45
    v_fmac_f32 v26, v43, v46
    v_fmac_f32 v27, v43, v47
    v_fmac_f32 v28, v43, v48
    v_fmac_f32 v29, v43, v49
    v_fmac_f32 v30, v43, v50
    v_fmac_f32 v31, v43, v51
    s_waitcnt vmcnt(4)
    v_dot2_f32_bf16 v36, v96, v8, 0
    v_dot2_f32_bf16 v37, v96, v12, 0
    v_dot2_f32_bf16 v38, v100, v8, 0
    v_dot2_f32_bf16 v39, v100, v12, 0
    v_dot2_f32_bf16 v40, v104, v8, 0
    v_dot2_f32_bf16 v41, v104, v12, 0
    v_dot2_f32_bf16 v42, v108, v8, 0
    v_dot2_f32_bf16 v43, v108, v12, 0
    v_dot2_f32_bf16 v36, v97, v9, v36
    v_dot2_f32_bf16 v37, v97, v13, v37
    v_dot2_f32_bf16 v38, v101, v9, v38
    v_dot2_f32_bf16 v39, v101, v13, v39
    v_dot2_f32_bf16 v40, v105, v9, v40
    v_dot2_f32_bf16 v41, v105, v13, v41
    v_dot2_f32_bf16 v42, v109, v9, v42
    v_dot2_f32_bf16 v43, v109, v13, v43
    v_dot2_f32_bf16 v36, v98, v10, v36
    v_dot2_f32_bf16 v37, v98, v14, v37
    v_dot2_f32_bf16 v38, v102, v10, v38
    v_dot2_f32_bf16 v39, v102, v14, v39
    v_dot2_f32_bf16 v40, v106, v10, v40
    v_dot2_f32_bf16 v41, v106, v14, v41
    v_dot2_f32_bf16 v42, v110, v10, v42
    v_dot2_f32_bf16 v43, v110, v14, v43
    v_dot2_f32_bf16 v36, v99, v11, v36
    v_dot2_f32_bf16 v37, v99, v15, v37
    v_dot2_f32_bf16 v38, v103, v11, v38
    v_dot2_f32_bf16 v39, v103, v15, v39
    v_dot2_f32_bf16 v40, v107, v11, v40
    v_dot2_f32_bf16 v41, v107, v15, v41
    v_dot2_f32_bf16 v42, v111, v11, v42
    v_dot2_f32_bf16 v43, v111, v15, v43
    v_add_f32_dpp v36, v36, v36 row_ror:8 row_mask:0xf bank_mask:0xf
    v_add_f32_dpp v37, v37, v37 row_ror:8 row_mask:0xf bank_mask:0xf
    v_add_f32_dpp v38, v38, v38 row_ror:8 row_mask:0xf bank_mask:0xf
    v_add_f32_dpp v39, v39, v39 row_ror:8 row_mask:0xf bank_mask:0xf
    v_add_f32_dpp v40, v40, v40 row_ror:8 row_mask:0xf bank_mask:0xf
    v_add_f32_dpp v41, v41, v41 row_ror:8 row_mask:0xf bank_mask:0xf
    v_add_f32_dpp v42, v42, v42 row_ror:8 row_mask:0xf bank_mask:0xf
    v_add_f32_dpp v43, v43, v43 row_ror:8 row_mask:0xf bank_mask:0xf
    v_add_f32_dpp v36, v36, v36 row_ror:4 row_mask:0xf bank_mask:0xf
    v_add_f32_dpp v37, v37, v37 row_ror:4 row_mask:0xf bank_mask:0xf
    v_add_f32_dpp v38, v38, v38 row_ror:4 row_mask:0xf bank_mask:0xf
    v_add_f32_dpp v39, v39, v39 row_ror:4 row_mask:0xf bank_mask:0xf
    v_add_f32_dpp v40, v40, v40 row_ror:4 row_mask:0xf bank_mask:0xf
    v_add_f32_dpp v41, v41, v41 row_ror:4 row_mask:0xf bank_mask:0xf
    v_add_f32_dpp v42, v42, v42 row_ror:4 row_mask:0xf bank_mask:0xf
    v_add_f32_dpp v43, v43, v43 row_ror:4 row_mask:0xf bank_mask:0xf
    v_add_f32_dpp v36, v36, v36 row_ror:2 row_mask:0xf bank_mask:0xf
    v_add_f32_dpp v37, v37, v37 row_ror:2 row_mask:0xf bank_mask:0xf
    v_add_f32_dpp v38, v38, v38 row_ror:2 row_mask:0xf bank_mask:0xf
    v_add_f32_dpp v39, v39, v39 row_ror:2 row_mask:0xf bank_mask:0xf
    v_add_f32_dpp v40, v40, v40 row_ror:2 row_mask:0xf bank_mask:0xf
    v_add_f32_dpp v41, v41, v41 row_ror:2 row_mask:0xf bank_mask:0xf
    v_add_f32_dpp v42, v42, v42 row_ror:2 row_mask:0xf bank_mask:0xf
    v_add_f32_dpp v43, v43, v43 row_ror:2 row_mask:0xf bank_mask:0xf
    v_add_f32_dpp v36, v36, v36 row_ror:1 row_mask:0xf bank_mask:0xf
    v_add_f32_dpp v37, v37, v37 row_ror:1 row_mask:0xf bank_mask:0xf
    v_add_f32_dpp v38, v38, v38 row_ror:1 row_mask:0xf bank_mask:0xf
    v_add_f32_dpp v39, v39, v39 row_ror:1 row_mask:0xf bank_mask:0xf
    v_add_f32_dpp v40, v40, v40 row_ror:1 row_mask:0xf bank_mask:0xf
    v_add_f32_dpp v41, v41, v41 row_ror:1 row_mask:0xf bank_mask:0xf
    v_add_f32_dpp v42, v42, v42 row_ror:1 row_mask:0xf bank_mask:0xf
    v_add_f32_dpp v43, v43, v43 row_ror:1 row_mask:0xf bank_mask:0xf
    v_mul_f32 v36, s68, v36
    v_mul_f32 v37, s68, v37
    v_mul_f32 v38, s68, v38
    v_mul_f32 v39, s68, v39
    v_mul_f32 v40, s68, v40
    v_mul_f32 v41, s68, v41
    v_mul_f32 v42, s68, v42
    v_mul_f32 v43, s68, v43
    v_max3_f32 v52, v36, v38, v40
    v_max3_f32 v53, v37, v39, v41
    v_max3_f32 v52, v52, v42, v32
    v_max3_f32 v53, v53, v43, v33
    v_sub_f32 v54, v32, v52
    v_sub_f32 v55, v33, v53
    v_sub_f32 v36, v36, v52
    v_sub_f32 v37, v37, v53
    v_sub_f32 v38, v38, v52
    v_sub_f32 v39, v39, v53
    v_sub_f32 v40, v40, v52
    v_sub_f32 v41, v41, v53
    v_sub_f32 v42, v42, v52
    v_sub_f32 v43, v43, v53
    v_exp_f32 v54, v54
    v_exp_f32 v55, v55
    v_exp_f32 v36, v36
    v_exp_f32 v37, v37
    v_exp_f32 v38, v38
    v_exp_f32 v39, v39
    v_exp_f32 v40, v40
    v_exp_f32 v41, v41
    v_exp_f32 v42, v42
    v_exp_f32 v43, v43
    v_mov_b32 v32, v52
    v_mov_b32 v33, v53
    v_fma_f32 v34, v34, v54, v36
    v_fma_f32 v35, v35, v55, v37
    v_add_f32 v34, v34, v38
    v_add_f32 v35, v35, v39
    v_add_f32 v34, v34, v40
    v_add_f32 v35, v35, v41
    v_add_f32 v34, v34, v42
    v_add_f32 v35, v35, v43
    v_mul_f32 v16, v54, v16
    v_mul_f32 v17, v54, v17
    v_mul_f32 v18, v54, v18
    v_mul_f32 v19, v54, v19
    v_mul_f32 v20, v54, v20
    v_mul_f32 v21, v54, v21
    v_mul_f32 v22, v54, v22
    v_mul_f32 v23, v54, v23
    v_mul_f32 v24, v55, v24
    v_mul_f32 v25, v55, v25
    v_mul_f32 v26, v55, v26
    v_mul_f32 v27, v55, v27
    v_mul_f32 v28, v55, v28
    v_mul_f32 v29, v55, v29
    v_mul_f32 v30, v55, v30
    v_mul_f32 v31, v55, v31
    s_waitcnt vmcnt(0)
    v_lshlrev_b32 v44, 16, v112
    v_and_b32 v45, s69, v112
    v_lshlrev_b32 v46, 16, v113
    v_and_b32 v47, s69, v113
    v_lshlrev_b32 v48, 16, v114
    v_and_b32 v49, s69, v114
    v_lshlrev_b32 v50, 16, v115
    v_and_b32 v51, s69, v115
    v_fmac_f32 v16, v36, v44
    v_fmac_f32 v17, v36, v45
    v_fmac_f32 v18, v36, v46
    v_fmac_f32 v19, v36, v47
    v_fmac_f32 v20, v36, v48
    v_fmac_f32 v21, v36, v49
    v_fmac_f32 v22, v36, v50
    v_fmac_f32 v23, v36, v51
    v_fmac_f32 v24, v37, v44
    v_fmac_f32 v25, v37, v45
    v_fmac_f32 v26, v37, v46
    v_fmac_f32 v27, v37, v47
    v_fmac_f32 v28, v37, v48
    v_fmac_f32 v29, v37, v49
    v_fmac_f32 v30, v37, v50
    v_fmac_f32 v31, v37, v51
    v_lshlrev_b32 v44, 16, v116
    v_and_b32 v45, s69, v116
    v_lshlrev_b32 v46, 16, v117
    v_and_b32 v47, s69, v117
    v_lshlrev_b32 v48, 16, v118
    v_and_b32 v49, s69, v118
    v_lshlrev_b32 v50, 16, v119
    v_and_b32 v51, s69, v119
    v_fmac_f32 v16, v38, v44
    v_fmac_f32 v17, v38, v45
    v_fmac_f32 v18, v38, v46
    v_fmac_f32 v19, v38, v47
    v_fmac_f32 v20, v38, v48
    v_fmac_f32 v21, v38, v49
    v_fmac_f32 v22, v38, v50
    v_fmac_f32 v23, v38, v51
    v_fmac_f32 v24, v39, v44
    v_fmac_f32 v25, v39, v45
    v_fmac_f32 v26, v39, v46
    v_fmac_f32 v27, v39, v47
    v_fmac_f32 v28, v39, v48
    v_fmac_f32 v29, v39, v49
    v_fmac_f32 v30, v39, v50
    v_fmac_f32 v31, v39, v51
    v_lshlrev_b32 v44, 16, v120
    v_and_b32 v45, s69, v120
    v_lshlrev_b32 v46, 16, v121
    v_and_b32 v47, s69, v121
    v_lshlrev_b32 v48, 16, v122
    v_and_b32 v49, s69, v122
    v_lshlrev_b32 v50, 16, v123
    v_and_b32 v51, s69, v123
    v_fmac_f32 v16, v40, v44
    v_fmac_f32 v17, v40, v45
    v_fmac_f32 v18, v40, v46
    v_fmac_f32 v19, v40, v47
    v_fmac_f32 v20, v40, v48
    v_fmac_f32 v21, v40, v49
    v_fmac_f32 v22, v40, v50
    v_fmac_f32 v23, v40, v51
    v_fmac_f32 v24, v41, v44
    v_fmac_f32 v25, v41, v45
    v_fmac_f32 v26, v41, v46
    v_fmac_f32 v27, v41, v47
    v_fmac_f32 v28, v41, v48
    v_fmac_f32 v29, v41, v49
    v_fmac_f32 v30, v41, v50
    v_fmac_f32 v31, v41, v51
    v_lshlrev_b32 v44, 16, v124
    v_and_b32 v45, s69, v124
    v_lshlrev_b32 v46, 16, v125
    v_and_b32 v47, s69, v125
    v_lshlrev_b32 v48, 16, v126
    v_and_b32 v49, s69, v126
    v_lshlrev_b32 v50, 16, v127
    v_and_b32 v51, s69, v127
    v_fmac_f32 v16, v42, v44
    v_fmac_f32 v17, v42, v45
    v_fmac_f32 v18, v42, v46
    v_fmac_f32 v19, v42, v47
    v_fmac_f32 v20, v42, v48
    v_fmac_f32 v21, v42, v49
    v_fmac_f32 v22, v42, v50
    v_fmac_f32 v23, v42, v51
    v_fmac_f32 v24, v43, v44
    v_fmac_f32 v25, v43, v45
    v_fmac_f32 v26, v43, v46
    v_fmac_f32 v27, v43, v47
    v_fmac_f32 v28, v43, v48
    v_fmac_f32 v29, v43, v49
    v_fmac_f32 v30, v43, v50
    v_fmac_f32 v31, v43, v51
    v_lshrrev_b32 v44, 4, v0
    v_lshlrev_b32 v45, 10, v44
    v_lshl_add_u32 v45, v7, 1, v45
    ds_write_b128 v45, v[16:19]
    ds_write_b128 v45, v[20:23] offset:16
    ds_write_b128 v45, v[24:27] offset:512
    ds_write_b128 v45, v[28:31] offset:528
    v_lshlrev_b32 v46, 4, v44
    v_mov_b32 v48, v32
    v_mov_b32 v49, v34
    v_mov_b32 v50, v33
    v_mov_b32 v51, v35
    v_cmp_eq_u32 vcc, 0, v7
    s_and_saveexec_b64 s[70:71], vcc
    ds_write_b128 v46, v[48:51] offset:16384
    s_mov_b64 exec, s[70:71]
    v_lshlrev_b32 v2, 16, v2
    v_lshlrev_b32 v3, 16, v3
    v_lshlrev_b32 v4, 16, v4
    v_lshlrev_b32 v5, 16, v5
    v_mul_f32 v47, v2, v3
    s_nop 1
    v_add_f32_dpp v47, v47, v47 row_ror:8 row_mask:0xf bank_mask:0xf
    s_nop 1
    v_add_f32_dpp v47, v47, v47 row_ror:4 row_mask:0xf bank_mask:0xf
    s_nop 1
    v_add_f32_dpp v47, v47, v47 row_ror:2 row_mask:0xf bank_mask:0xf
    s_nop 1
    v_add_f32_dpp v47, v47, v47 row_ror:1 row_mask:0xf bank_mask:0xf
    s_nop 1
    v_lshlrev_b32 v46, 2, v44
    v_cmp_gt_u32 s[76:77], 16, v44
    v_cmp_eq_u32 vcc, 0, v7
    s_and_b64 vcc, vcc, s[76:77]
    s_and_saveexec_b64 s[70:71], vcc
    ds_write_b32 v46, v47 offset:16640
    s_mov_b64 exec, s[70:71]
    s_waitcnt lgkmcnt(0)
    s_barrier
    v_lshlrev_b32 v44, 3, v57
    v_lshlrev_b32 v45, 2, v56
    v_lshl_add_u32 v45, v57, 9, v45
    v_mov_b32 v48, 0xf149f2ca
    v_mov_b32 v49, 0
    v_mov_b32 v50, 0
    ds_read_b64 v[64:65], v44 offset:16384
    ds_read_b64 v[66:67], v44 offset:16400
    ds_read_b64 v[68:69], v44 offset:16416
    ds_read_b64 v[70:71], v44 offset:16432
    ds_read_b64 v[72:73], v44 offset:16448
    ds_read_b64 v[74:75], v44 offset:16464
    ds_read_b64 v[76:77], v44 offset:16480
    ds_read_b64 v[78:79], v44 offset:16496
    ds_read_b64 v[80:81], v44 offset:16512
    ds_read_b64 v[82:83], v44 offset:16528
    ds_read_b64 v[84:85], v44 offset:16544
    ds_read_b64 v[86:87], v44 offset:16560
    ds_read_b64 v[88:89], v44 offset:16576
    ds_read_b64 v[90:91], v44 offset:16592
    ds_read_b64 v[92:93], v44 offset:16608
    ds_read_b64 v[94:95], v44 offset:16624
    ds_read_b32 v96, v45 offset:0
    ds_read_b32 v97, v45 offset:1024
    ds_read_b32 v98, v45 offset:2048
    ds_read_b32 v99, v45 offset:3072
    ds_read_b32 v100, v45 offset:4096
    ds_read_b32 v101, v45 offset:5120
    ds_read_b32 v102, v45 offset:6144
    ds_read_b32 v103, v45 offset:7168
    ds_read_b32 v104, v45 offset:8192
    ds_read_b32 v105, v45 offset:9216
    ds_read_b32 v106, v45 offset:10240
    ds_read_b32 v107, v45 offset:11264
    ds_read_b32 v108, v45 offset:12288
    ds_read_b32 v109, v45 offset:13312
    ds_read_b32 v110, v45 offset:14336
    ds_read_b32 v111, v45 offset:15360
    s_waitcnt lgkmcnt(0)
    v_mov_b32 v51, v48
    v_max_f32 v48, v48, v64
    v_max_f32 v48, v48, v66
    v_max_f32 v48, v48, v68
    v_max_f32 v48, v48, v70
    v_max_f32 v48, v48, v72
    v_max_f32 v48, v48, v74
    v_max_f32 v48, v48, v76
    v_max_f32 v48, v48, v78
    v_max_f32 v48, v48, v80
    v_max_f32 v48, v48, v82
    v_max_f32 v48, v48, v84
    v_max_f32 v48, v48, v86
    v_max_f32 v48, v48, v88
    v_max_f32 v48, v48, v90
    v_max_f32 v48, v48, v92
    v_max_f32 v48, v48, v94
    v_sub_f32 v51, v51, v48
    v_sub_f32 v64, v64, v48
    v_sub_f32 v66, v66, v48
    v_sub_f32 v68, v68, v48
    v_sub_f32 v70, v70, v48
    v_sub_f32 v72, v72, v48
    v_sub_f32 v74, v74, v48
    v_sub_f32 v76, v76, v48
    v_sub_f32 v78, v78, v48
    v_sub_f32 v80, v80, v48
    v_sub_f32 v82, v82, v48
    v_sub_f32 v84, v84, v48
    v_sub_f32 v86, v86, v48
    v_sub_f32 v88, v88, v48
    v_sub_f32 v90, v90, v48
    v_sub_f32 v92, v92, v48
    v_sub_f32 v94, v94, v48
    v_exp_f32 v51, v51
    v_exp_f32 v64, v64
    v_exp_f32 v66, v66
    v_exp_f32 v68, v68
    v_exp_f32 v70, v70
    v_exp_f32 v72, v72
    v_exp_f32 v74, v74
    v_exp_f32 v76, v76
    v_exp_f32 v78, v78
    v_exp_f32 v80, v80
    v_exp_f32 v82, v82
    v_exp_f32 v84, v84
    v_exp_f32 v86, v86
    v_exp_f32 v88, v88
    v_exp_f32 v90, v90
    v_exp_f32 v92, v92
    v_exp_f32 v94, v94
    s_nop 0
    v_mul_f32 v49, v49, v51
    v_mul_f32 v50, v50, v51
    v_fmac_f32 v49, v64, v65
    v_fmac_f32 v50, v64, v96
    v_fmac_f32 v49, v66, v67
    v_fmac_f32 v50, v66, v97
    v_fmac_f32 v49, v68, v69
    v_fmac_f32 v50, v68, v98
    v_fmac_f32 v49, v70, v71
    v_fmac_f32 v50, v70, v99
    v_fmac_f32 v49, v72, v73
    v_fmac_f32 v50, v72, v100
    v_fmac_f32 v49, v74, v75
    v_fmac_f32 v50, v74, v101
    v_fmac_f32 v49, v76, v77
    v_fmac_f32 v50, v76, v102
    v_fmac_f32 v49, v78, v79
    v_fmac_f32 v50, v78, v103
    v_fmac_f32 v49, v80, v81
    v_fmac_f32 v50, v80, v104
    v_fmac_f32 v49, v82, v83
    v_fmac_f32 v50, v82, v105
    v_fmac_f32 v49, v84, v85
    v_fmac_f32 v50, v84, v106
    v_fmac_f32 v49, v86, v87
    v_fmac_f32 v50, v86, v107
    v_fmac_f32 v49, v88, v89
    v_fmac_f32 v50, v88, v108
    v_fmac_f32 v49, v90, v91
    v_fmac_f32 v50, v90, v109
    v_fmac_f32 v49, v92, v93
    v_fmac_f32 v50, v92, v110
    v_fmac_f32 v49, v94, v95
    v_fmac_f32 v50, v94, v111
    s_lshl_b32 s72, s2, 10
    s_lshl_b32 s73, s2, 4
    s_add_u32 s73, s73, 0x400000
    buffer_store_dword v50, v45, s[60:63], s72 offen sc1
    v_cmp_eq_u32 vcc, 0, v56
    s_and_saveexec_b64 s[70:71], vcc
    buffer_store_dwordx2 v[48:49], v44, s[60:63], s73 offen sc1
    s_mov_b64 exec, s[70:71]
    s_waitcnt vmcnt(0)
    s_barrier
    s_cmp_lg_u32 s24, 0
    s_cbranch_scc1 L_noatomic
    v_mov_b32 v44, 1
    v_mov_b32 v46, 0
    s_lshl_b32 s74, s22, 2
    s_mov_b64 exec, 1
    buffer_atomic_add v44, v46, s[56:59], s74 offen sc0 sc1
    s_waitcnt vmcnt(0)
    v_mov_b32 v46, 16704
    ds_write_b32 v46, v44
    s_mov_b64 exec, -1
    s_waitcnt lgkmcnt(0)
L_noatomic:
    s_barrier
    v_mov_b32 v46, 16704
    ds_read_b32 v44, v46
    s_waitcnt lgkmcnt(0)
    v_readfirstlane_b32 s75, v44
    s_cmp_lg_u32 s75, 7
    s_cbranch_scc1 L_end
    v_lshlrev_b32 v44, 3, v57
    s_lshl_b32 s72, s22, 13
    s_lshl_b32 s73, s22, 7
    s_add_u32 s73, s73, 0x400000
    buffer_load_dwordx2 v[64:65], v44, s[60:63], s73 offen sc1
    s_add_u32 s73, s73, 16
    buffer_load_dword v8, v45, s[60:63], s72 offen sc1
    s_add_u32 s72, s72, 1024
    buffer_load_dwordx2 v[66:67], v44, s[60:63], s73 offen sc1
    s_add_u32 s73, s73, 16
    buffer_load_dword v9, v45, s[60:63], s72 offen sc1
    s_add_u32 s72, s72, 1024
    buffer_load_dwordx2 v[68:69], v44, s[60:63], s73 offen sc1
    s_add_u32 s73, s73, 16
    buffer_load_dword v10, v45, s[60:63], s72 offen sc1
    s_add_u32 s72, s72, 1024
    buffer_load_dwordx2 v[70:71], v44, s[60:63], s73 offen sc1
    s_add_u32 s73, s73, 16
    buffer_load_dword v11, v45, s[60:63], s72 offen sc1
    s_add_u32 s72, s72, 1024
    buffer_load_dwordx2 v[72:73], v44, s[60:63], s73 offen sc1
    s_add_u32 s73, s73, 16
    buffer_load_dword v12, v45, s[60:63], s72 offen sc1
    s_add_u32 s72, s72, 1024
    buffer_load_dwordx2 v[74:75], v44, s[60:63], s73 offen sc1
    s_add_u32 s73, s73, 16
    buffer_load_dword v13, v45, s[60:63], s72 offen sc1
    s_add_u32 s72, s72, 1024
    buffer_load_dwordx2 v[76:77], v44, s[60:63], s73 offen sc1
    s_add_u32 s73, s73, 16
    buffer_load_dword v14, v45, s[60:63], s72 offen sc1
    s_add_u32 s72, s72, 1024
    buffer_load_dwordx2 v[78:79], v44, s[60:63], s73 offen sc1
    s_add_u32 s73, s73, 16
    buffer_load_dword v15, v45, s[60:63], s72 offen sc1
    s_add_u32 s72, s72, 1024
    v_lshlrev_b32 v46, 5, v57
    ds_read_b128 v[48:51], v46 offset:16640
    ds_read_b128 v[52:55], v46 offset:16656
    s_waitcnt lgkmcnt(0)
    v_add_f32 v48, v48, v49
    v_add_f32 v50, v50, v51
    v_add_f32 v52, v52, v53
    v_add_f32 v54, v54, v55
    v_add_f32 v48, v48, v50
    v_add_f32 v52, v52, v54
    v_add_f32 v6, v48, v52
    v_mul_f32 v6, s68, v6
    v_sub_f32 v47, 1.0, v5
    v_mov_b32 v46, 0xceabfb8f
    v_fmac_f32 v6, v47, v46
    s_waitcnt vmcnt(0)
    v_mov_b32 v48, v64
    v_max_f32 v48, v48, v66
    v_max_f32 v48, v48, v68
    v_max_f32 v48, v48, v70
    v_max_f32 v48, v48, v72
    v_max_f32 v48, v48, v74
    v_max_f32 v48, v48, v76
    v_max_f32 v48, v48, v78
    v_max_f32 v48, v48, v6
    v_sub_f32 v64, v64, v48
    v_sub_f32 v66, v66, v48
    v_sub_f32 v68, v68, v48
    v_sub_f32 v70, v70, v48
    v_sub_f32 v72, v72, v48
    v_sub_f32 v74, v74, v48
    v_sub_f32 v76, v76, v48
    v_sub_f32 v78, v78, v48
    v_exp_f32 v64, v64
    v_exp_f32 v66, v66
    v_exp_f32 v68, v68
    v_exp_f32 v70, v70
    v_exp_f32 v72, v72
    v_exp_f32 v74, v74
    v_exp_f32 v76, v76
    v_exp_f32 v78, v78
    s_nop 0
    v_mul_f32 v49, v64, v65
    v_mul_f32 v50, v64, v8
    v_fmac_f32 v49, v66, v67
    v_fmac_f32 v50, v66, v9
    v_fmac_f32 v49, v68, v69
    v_fmac_f32 v50, v68, v10
    v_fmac_f32 v49, v70, v71
    v_fmac_f32 v50, v70, v11
    v_fmac_f32 v49, v72, v73
    v_fmac_f32 v50, v72, v12
    v_fmac_f32 v49, v74, v75
    v_fmac_f32 v50, v74, v13
    v_fmac_f32 v49, v76, v77
    v_fmac_f32 v50, v76, v14
    v_fmac_f32 v49, v78, v79
    v_fmac_f32 v50, v78, v15
    v_sub_f32 v6, v6, v48
    v_exp_f32 v6, v6
    s_nop 0
    v_add_f32 v49, v49, v6
    v_fmac_f32 v50, v6, v4
    v_rcp_f32 v49, v49
    s_nop 0
    v_mul_f32 v50, v50, v49
    v_cvt_pk_bf16_f32 v50, v50, v50
    buffer_store_short v50, v59, s[52:55], s25 offen
L_end:
s_endpgm
.section .rodata,"a"
.p2align 6
.amdhsa_kernel standalone__tree_speculative_verify_tree_attention_over_candidate_token_tree__decode_kernel
  .amdhsa_next_free_vgpr 128
  .amdhsa_next_free_sgpr 80
  .amdhsa_accum_offset 128
  .amdhsa_group_segment_fixed_size 0
  .amdhsa_kernarg_size 72
  .amdhsa_user_sgpr_count 2
  .amdhsa_user_sgpr_kernarg_segment_ptr 1
  .amdhsa_system_sgpr_workgroup_id_x 1
.end_amdhsa_kernel
```
